```python
import torch

def _softmax(x, axis=-1):
    return torch.softmax(x, dim=axis)
def _gelu(x):
    return torch.nn.functional.gelu(x, approximate="tanh")
def _silu(x):
    return torch.nn.functional.silu(x)
def _sigmoid(x):
    return torch.sigmoid(x)
def _layernorm(x, axis=-1, eps=1e-5):
    m = x.mean(dim=axis, keepdim=True)
    v = x.var(dim=axis, keepdim=True, unbiased=False)
    return (x - m) / torch.sqrt(v + eps)
def _scatter_add(tgt, idx, src, axis=0):
    return tgt.clone().index_add_(axis, idx, src)
def _segment_sum(src, seg, n):
    out = torch.zeros((n,) + src.shape[1:], dtype=src.dtype)
    return out.index_add_(0, seg, src)
def _pad(x, pw):
    flat = tuple(v for pair in reversed(pw) for v in pair)
    return torch.nn.functional.pad(x, flat)

kernel_name = 'interleave_layers__sliding_block_cached__mixer_channel_mlp__decode'

def setup_inputs():

    _w = (lambda a: (lambda t: t.to(torch.bfloat16) if t.is_floating_point() else t)(torch.as_tensor(a)))
    def _A_setup():
        B, Sq, D = 4, 1, 512
        Hq, Hkv, Sk, Dh = 32, 8, 8192, 128
        assert Hq % Hkv == 0, (Hq, Hkv)
        return {
            "x": _w((lambda *s: torch.randn(*s, dtype=torch.bfloat16) * 0.05)(B, Sq, D)),
            "k_cache": _w((lambda *s: torch.randn(*s, dtype=torch.bfloat16) * 1.6)(B, Hkv, Sk, Dh)),
            "v_cache": _w((lambda *s: torch.randn(*s, dtype=torch.bfloat16) * 1.6)(B, Hkv, Sk, Dh)),
            "wq": _w((lambda *s: torch.randn(*s, dtype=torch.bfloat16) * 1.6)(D, Hq * Dh) * (D ** -0.5)),
            "wo": _w((lambda *s: torch.randn(*s, dtype=torch.bfloat16) * 1.6)(Hq * Dh, D) * ((Hq * Dh) ** -0.5)),
        }
    _A_in = _A_setup()

    def _B_setup():
        B, S, D, F = 4, 1, 512, 1792
        return {
            "x": _w((lambda *s: torch.randn(*s, dtype=torch.bfloat16) * 0.05)(B, S, D)),
            "w1": _w((lambda *s: torch.randn(*s, dtype=torch.bfloat16) * 3.2)(D, F) * (D ** -0.5)),
            "b1": _w((lambda *s: torch.randn(*s, dtype=torch.bfloat16) * 1.6)(F)),
            "w2": _w((lambda *s: torch.randn(*s, dtype=torch.bfloat16) * 0.2)(F, D) * (F ** -0.5)),
            "b2": _w((lambda *s: torch.randn(*s, dtype=torch.bfloat16) * 0.2)(D)),
        }
    _B_in = _B_setup()

    return {
        "A_x": _A_in["x"],
        "A_k_cache": _A_in["k_cache"],
        "A_v_cache": _A_in["v_cache"],
        "A_wq": _A_in["wq"],
        "A_wo": _A_in["wo"],
        "B_x": _B_in["x"],
        "B_w1": _B_in["w1"],
        "B_b1": _B_in["b1"],
        "B_w2": _B_in["w2"],
        "B_b2": _B_in["b2"],
    }

def reference(A_x, A_k_cache, A_v_cache, A_wq, A_wo, B_x, B_w1, B_b1, B_w2, B_b2):
    def _A_ref(x, k_cache, v_cache, wq, wo):
        B, Sq, D = x.shape
        Hq, Dh = 32, 128
        Hkv, Sk = k_cache.shape[1], k_cache.shape[2]
        W = min(4096, max(256, Sk // 4))
        rep = Hq // Hkv
        q = (lambda x, *d: x.permute(*d))((x @ wq).reshape(B, Sq, Hq, Dh), 0, 2, 1, 3)
        k = (lambda x, n, axis: torch.repeat_interleave(x, n, dim=axis))(k_cache[:, :, Sk - W:, :], rep, axis=1)
        v = (lambda x, n, axis: torch.repeat_interleave(x, n, dim=axis))(v_cache[:, :, Sk - W:, :], rep, axis=1)
        scores = torch.einsum("bhqd,bhkd->bhqk", q, k) * (Dh ** -0.5)
        p = _softmax(scores, axis=-1)
        o = torch.einsum("bhqk,bhkd->bhqd", p, v)
        return (lambda x, *d: x.permute(*d))(o, 0, 2, 1, 3).reshape(B, Sq, Hq * Dh) @ wo

    def _B_ref(x, w1, b1, w2, b2):
        y = _layernorm(x, axis=-1)
        h = _gelu(torch.einsum("bsd,df->bsf", y, w1) + b1)
        return torch.einsum("bsf,fd->bsd", h, w2) + b2

    x = A_x
    x = x + _A_ref(_layernorm(x, axis=-1), A_k_cache, A_v_cache, A_wq, A_wo)
    x = x + _B_ref(_layernorm(x, axis=-1), B_w1, B_b1, B_w2, B_b2)
    x = x + _A_ref(_layernorm(x, axis=-1), A_k_cache, A_v_cache, A_wq, A_wo)
    x = x + _B_ref(_layernorm(x, axis=-1), B_w1, B_b1, B_w2, B_b2)
    return x
```

```asm
; @launch grid=(256,1,1) block=(768,1,1) lds=93184
.amdgcn_target "amdgcn-amd-amdhsa--gfx950"
.text
.globl interleave_layers__sliding_block_cached__mixer_channel_mlp__decode_kernel
.p2align 8
.type interleave_layers__sliding_block_cached__mixer_channel_mlp__decode_kernel,@function
interleave_layers__sliding_block_cached__mixer_channel_mlp__decode_kernel:
    s_getpc_b64 s[46:47]
    s_cmp_ge_u32 s2, 256
    s_cbranch_scc1 L_END
    s_load_dwordx16 s[16:31], s[0:1], 0
    s_load_dwordx8 s[32:39], s[0:1], 64
    s_load_dwordx2 s[40:41], s[0:1], 96
    v_lshlrev_b32 v3, 4, v0
    global_load_dwordx4 v[140:143], v3, s[46:47] offset:-4
    v_lshrrev_b32 v1, 6, v0
    v_and_b32 v0, 63, v0
    v_readfirstlane_b32 s3, v1
    s_and_b32 s4, s2, 7
    s_lshr_b32 s5, s2, 3
    s_lshr_b32 s6, s2, 6
    s_and_b32 s7, s5, 7
    s_lshr_b32 s8, s2, 4
    s_and_b32 s9, s5, 1
    s_mov_b32 s10, 0
    s_mov_b32 s11, 1000000
    v_and_b32 v1, 15, v0
    v_lshrrev_b32 v2, 4, v0
    v_lshlrev_b32 v3, 4, v0
    s_mov_b32 s45, s3
    s_sub_u32 s3, s3, 4
    s_cbranch_scc0 L_G
    s_add_u32 s3, s45, 8
    v_mov_b32 v4, 73792
    v_mov_b32 v6, 0
    v_mov_b32 v7, 0
    ds_write_b64 v4, v[6:7]
    ds_write_b64 v4, v[6:7] offset:8
    v_mov_b32 v8, 0x7f817f81
    v_mov_b32 v9, 0x7f817f81
    v_mov_b32 v10, 0x7f817f81
    v_mov_b32 v11, 0x7f817f81
    s_and_b32 s67, s45, 1
    s_lshr_b32 s68, s45, 1
    s_mul_i32 s12, s5, 6144
    s_mul_i32 s15, s45, 1536
    s_add_u32 s12, s12, s15
    v_add_u32 v7, s12, v3
    s_mul_i32 s12, s2, 1280
    s_lshl_b32 s15, s67, 21
    s_add_u32 s12, s12, s15
    s_mul_i32 s15, s68, 640
    s_add_u32 s12, s12, s15
    s_add_u32 s12, s12, 1572864
    v_add_u32 v12, s12, v3
    s_mul_i32 s12, s4, 196608
    v_lshrrev_b32 v13, 3, v0
    v_and_b32 v14, 7, v0
    v_lshlrev_b32 v120, 13, v13
    v_lshl_add_u32 v120, v14, 4, v120
    s_lshl_b32 s13, s6, 20
    s_lshl_b32 s15, s45, 18
    s_add_u32 s13, s13, s15
    s_lshl_b32 s15, s4, 10
    s_add_u32 s13, s13, s15
    s_lshl_b32 s15, s7, 7
    s_add_u32 s13, s13, s15
    s_lshl_b32 s14, s45, 10
    v_add_u32 v121, s14, v3
    s_waitcnt lgkmcnt(0)
    s_add_u32 s72, s40, s12
    s_addc_u32 s73, s41, 0
    s_add_u32 s62, s22, s13
    s_addc_u32 s63, s23, 0
    v_mov_b32 v4, 0
    s_or_b32 s12, s2, s45
    s_cbranch_scc1 S_NONONCE
    s_memrealtime s[48:49]
    s_waitcnt lgkmcnt(0)
    s_or_b32 s48, s48, 1
    v_mov_b32 v123, s49
    v_mov_b32 v122, s48
    s_mov_b64 exec, 1
    global_store_dwordx2 v4, v[122:123], s[38:39] sc1
    s_mov_b64 exec, -1
S_NONONCE:
    s_cmp_lg_u32 s45, 3
    s_cbranch_scc1 S_NE_SKIP
    global_load_dwordx2 v[136:137], v4, s[38:39] sc1
S_NE_SKIP:
    global_load_dwordx4 v[132:135], v121, s[16:17]
    s_lshl_b32 s13, s45, 12
    s_add_u32 m0, s13, 0
    s_nop 0
    global_load_lds_dwordx4 v120, s[62:63]
    s_add_u32 s62, s62, 65536
    s_addc_u32 s63, s63, 0
    s_add_u32 m0, s13, 1024
    s_nop 0
    global_load_lds_dwordx4 v120, s[62:63]
    s_add_u32 s62, s62, 65536
    s_addc_u32 s63, s63, 0
    s_add_u32 m0, s13, 2048
    s_nop 0
    global_load_lds_dwordx4 v120, s[62:63]
    s_add_u32 s62, s62, 65536
    s_addc_u32 s63, s63, 0
    s_add_u32 m0, s13, 3072
    s_nop 0
    global_load_lds_dwordx4 v120, s[62:63]
    global_store_dwordx4 v7, v[8:11], s[72:73] sc1
    s_mov_b32 exec_lo, 0xffffffff
    s_mov_b32 exec_hi, 0x00000000
    global_store_dwordx4 v7, v[8:11], s[72:73] offset:1024 sc1
    s_mov_b32 exec_lo, 0xffffffff
    s_mov_b32 exec_hi, 0x000000ff
    global_store_dwordx4 v12, v[8:11], s[40:41] sc1
    s_mov_b64 exec, -1
    s_barrier
    s_cmp_lg_u32 s45, 3
    s_cbranch_scc1 S_NP_SKIP
    v_mov_b32 v4, 0
    s_waitcnt vmcnt(8)
    v_mov_b32 v6, v136
    v_mov_b32 v7, v137
    s_branch S_NP_C
S_NP:
    global_load_dwordx2 v[6:7], v4, s[38:39] sc1
    s_waitcnt vmcnt(0)
S_NP_C:
    v_cmp_eq_u32 vcc, 0, v6
    s_nop 0
    s_cbranch_vccz S_NP_DONE
    s_sleep 3
    s_sub_u32 s11, s11, 1
    s_cbranch_scc0 S_NP
    s_mov_b32 s11, 0
S_NP_DONE:
    v_mov_b32 v5, 73840
    ds_write_b64 v5, v[6:7]
    s_waitcnt lgkmcnt(0)
S_NP_SKIP:
    s_getreg_b32 s66, hwreg(HW_REG_XCC_ID)
    s_and_b32 s66, s66, 7
    s_mov_b32 s42, s40
    s_mov_b32 s43, s41
    s_mov_b32 s44, 0
    s_mul_i32 s12, s5, 6144
    s_mul_i32 s15, s45, 1536
    s_add_u32 s12, s12, s15
    v_add_u32 v166, s12, v3
    v_mov_b32 v12, 0x3f803f80
    v_lshlrev_b32 v13, 2, v0
    v_add_u32 v13, 69888, v13
    ds_write_b32 v13, v12
    v_lshlrev_b32 v13, 2, v1
    v_add_u32 v13, 73024, v13
    ds_write_b32 v13, v12
    v_lshrrev_b32 v12, 2, v1
    v_min_u32 v13, 4, v1
    v_and_b32 v14, 3, v1
    v_mul_u32_u24 v144, 320, v12
    v_lshl_add_u32 v144, v2, 4, v144
    v_add_u32 v144, 68608, v144
    s_lshl_b32 s12, s45, 6
    s_add_u32 s12, s12, 68608
    v_mul_u32_u24 v145, 320, v13
    v_lshl_add_u32 v145, v2, 4, v145
    v_add_u32 v145, s12, v145
    v_mul_u32_u24 v146, 320, v12
    v_lshl_add_u32 v146, v2, 4, v146
    v_add_u32 v146, 71488, v146
    v_lshlrev_b32 v147, 6, v12
    v_lshl_add_u32 v147, v2, 4, v147
    v_add_u32 v147, 72768, v147
    v_lshlrev_b32 v148, 6, v13
    v_lshl_add_u32 v148, v2, 4, v148
    v_add_u32 v148, 72768, v148
    v_lshlrev_b32 v149, 4, v2
    v_add_u32 v149, 73088, v149
    s_lshl_b32 s12, s6, 11
    s_lshl_b32 s15, s7, 8
    s_add_u32 s12, s12, s15
    s_lshl_b32 s15, s45, 6
    s_add_u32 s12, s12, s15
    v_lshlrev_b32 v150, 13, v2
    v_lshl_add_u32 v150, v1, 2, v150
    v_add_u32 v150, s12, v150
    v_lshlrev_b32 v123, 7, v2
    v_lshlrev_b32 v124, 2, v12
    v_sub_u32 v123, v123, v124
    s_lshl_b32 s12, s7, 9
    s_lshl_b32 s15, s6, 5
    s_add_u32 s12, s12, s15
    s_lshl_b32 s15, s45, 3
    s_add_u32 s12, s12, s15
    s_add_u32 s12, s12, 40964
    v_add_u32 v151, s12, v123
    s_lshl_b32 s12, s8, 3
    s_add_u32 s12, s12, 193540
    v_add_u32 v162, s12, v123
    s_lshl_b32 s12, s8, 6
    s_add_u32 s12, s12, 188416
    v_lshlrev_b32 v163, 10, v14
    v_lshl_add_u32 v163, v2, 4, v163
    v_add_u32 v163, s12, v163
    v_and_b32 v123, 31, v0
    v_lshrrev_b32 v124, 5, v0
    s_lshl_b32 s12, s6, 13
    s_lshl_b32 s15, s45, 9
    s_add_u32 s12, s12, s15
    v_lshlrev_b32 v152, 12, v124
    v_lshl_add_u32 v152, v123, 4, v152
    v_add_u32 v152, s12, v152
    s_lshl_b32 s12, s7, 9
    s_lshl_b32 s15, s6, 7
    s_add_u32 s12, s12, s15
    s_add_u32 s12, s12, 40960
    v_lshlrev_b32 v153, 3, v1
    v_lshl_add_u32 v153, v2, 2, v153
    v_add_u32 v153, s12, v153
    s_mul_i32 s12, s45, 320
    s_add_u32 s12, s12, 70208
    v_lshlrev_b32 v154, 3, v123
    v_lshl_add_u32 v154, v124, 2, v154
    v_add_u32 v154, s12, v154
    v_bfe_u32 v125, v0, 4, 1
    v_bfe_u32 v126, v0, 2, 2
    v_and_b32 v127, 3, v0
    s_mul_i32 s12, s45, 288
    s_add_u32 s12, s12, 74752
    v_mul_u32_u24 v157, 9216, v124
    v_lshl_add_u32 v157, v1, 4, v157
    v_add_u32 v157, s12, v157
    v_mul_u32_u24 v125, 1152, v125
    v_add_u32 v157, v157, v125
    s_lshl_b32 s12, s45, 6
    s_add_u32 s12, s12, 73536
    v_lshlrev_b32 v158, 5, v124
    v_add_u32 v158, s12, v158
    s_lshl_b32 s12, s45, 14
    s_lshl_b32 s15, s5, 9
    s_add_u32 s12, s12, s15
    s_add_u32 s12, s12, 65536
    v_lshlrev_b32 v159, 3, v0
    v_add_u32 v159, s12, v159
    s_lshl_b32 s60, s45, 8
    s_lshl_b32 s15, s5, 3
    s_add_u32 s60, s60, s15
    s_add_u32 s60, s60, 61440
    s_lshl_b32 s12, s7, 14
    s_lshl_b32 s15, s68, 13
    s_add_u32 s12, s12, s15
    s_lshl_b32 s15, s4, 7
    s_add_u32 s12, s12, s15
    s_lshl_b32 s15, s6, 5
    s_add_u32 s12, s12, s15
    s_lshl_b32 s15, s67, 12
    s_add_u32 s12, s12, s15
    s_add_u32 s12, s12, 1572864
    v_lshlrev_b32 v160, 10, v2
    v_lshl_add_u32 v160, v1, 1, v160
    v_add_u32 v160, s12, v160
    s_mul_i32 s12, s8, 896
    s_mul_i32 s15, s9, 448
    s_add_u32 s12, s12, s15
    s_lshl_b32 s15, s45, 7
    s_add_u32 s12, s12, s15
    s_add_u32 s12, s12, 131072
    v_mul_u32_u24 v161, 14336, v2
    v_lshl_add_u32 v161, v1, 2, v161
    v_add_u32 v161, s12, v161
    s_lshl_b32 s12, s2, 8
    s_lshl_b32 s15, s45, 6
    s_add_u32 s12, s12, s15
    s_add_u32 s12, s12, 1835008
    v_lshlrev_b32 v164, 2, v1
    v_add_u32 v164, s12, v164
    v_lshl_add_u32 v123, v2, 3, v12
    s_lshl_b32 s12, s45, 5
    v_lshlrev_b32 v165, 7, v123
    v_lshl_add_u32 v165, v14, 3, v165
    v_add_u32 v165, s12, v165
    s_lshl_b32 s12, s45, 6
    v_mul_u32_u24 v167, 224, v123
    v_lshl_add_u32 v167, v14, 3, v167
    v_add_u32 v167, s12, v167
    s_waitcnt vmcnt(0)
    s_mul_i32 s12, s45, 320
    s_add_u32 s12, s12, 68608
    v_lshlrev_b32 v4, 4, v1
    v_add_u32 v4, s12, v4
    s_lshl_b32 s12, s6, 4
    s_mov_b32 s14, 0xffff
    s_mov_b32 s15, 0
    s_lshl_b64 exec, s[14:15], s12
    ds_write_b128 v4, v[132:135]
    s_mov_b64 exec, -1
    v_lshlrev_b32 v120, 16, v132
    v_and_b32 v121, 0xffff0000, v132
    v_lshlrev_b32 v122, 16, v133
    v_and_b32 v123, 0xffff0000, v133
    v_lshlrev_b32 v124, 16, v134
    v_and_b32 v125, 0xffff0000, v134
    v_lshlrev_b32 v126, 16, v135
    v_and_b32 v127, 0xffff0000, v135
    v_add_f32 v4, v120, v121
    v_mul_f32 v5, v120, v120
    v_fmac_f32 v5, v121, v121
    v_add_f32 v4, v4, v122
    v_fmac_f32 v5, v122, v122
    v_add_f32 v4, v4, v123
    v_fmac_f32 v5, v123, v123
    v_add_f32 v4, v4, v124
    v_fmac_f32 v5, v124, v124
    v_add_f32 v4, v4, v125
    v_fmac_f32 v5, v125, v125
    v_add_f32 v4, v4, v126
    v_fmac_f32 v5, v126, v126
    v_add_f32 v4, v4, v127
    v_fmac_f32 v5, v127, v127
    s_nop 0
    v_add_f32_dpp v4, v4, v4 quad_perm:[1,0,3,2] row_mask:0xf bank_mask:0xf
    v_add_f32_dpp v5, v5, v5 quad_perm:[1,0,3,2] row_mask:0xf bank_mask:0xf
    s_nop 0
    v_add_f32_dpp v4, v4, v4 quad_perm:[2,3,0,1] row_mask:0xf bank_mask:0xf
    v_add_f32_dpp v5, v5, v5 quad_perm:[2,3,0,1] row_mask:0xf bank_mask:0xf
    s_nop 0
    v_add_f32_dpp v4, v4, v4 row_half_mirror row_mask:0xf bank_mask:0xf
    v_add_f32_dpp v5, v5, v5 row_half_mirror row_mask:0xf bank_mask:0xf
    s_nop 0
    v_add_f32_dpp v4, v4, v4 row_mirror row_mask:0xf bank_mask:0xf
    v_add_f32_dpp v5, v5, v5 row_mirror row_mask:0xf bank_mask:0xf
    v_mov_b32 v6, v4
    s_nop 1
    v_permlane16_swap_b32 v4, v6
    v_add_f32 v4, v4, v6
    v_mov_b32 v6, v4
    s_nop 1
    v_permlane32_swap_b32 v4, v6
    v_add_f32 v4, v4, v6
    v_mov_b32 v6, v5
    s_nop 1
    v_permlane16_swap_b32 v5, v6
    v_add_f32 v5, v5, v6
    v_mov_b32 v6, v5
    s_nop 1
    v_permlane32_swap_b32 v5, v6
    v_add_f32 v5, v5, v6
    v_mul_f32 v4, 0x3b000000, v4
    v_mul_f32 v5, 0x3b000000, v5
    v_fma_f32 v5, -v4, v4, v5
    v_max_f32 v5, 0, v5
    v_add_f32 v5, 0x3727c5ac, v5
    v_rsq_f32 v5, v5
    s_lshl_b32 s12, s45, 3
    s_add_u32 s12, s12, 73808
    v_mov_b32 v6, s12
    ds_write_b64 v6, v[4:5]
    s_waitcnt lgkmcnt(0)
    v_mov_b32 v5, 73796
    v_mov_b32 v6, 1
    s_mov_b64 exec, 1
    ds_add_u32 v5, v6
    s_mov_b64 exec, -1
SSY_1:
    ds_read_b32 v6, v5
    s_waitcnt lgkmcnt(0)
    v_readfirstlane_b32 s12, v6
    s_nop 0
    s_cmp_eq_u32 s12, 4
    s_cbranch_scc1 SSD_2
    s_sub_u32 s11, s11, 1
    s_cbranch_scc0 SSY_1
    s_mov_b32 s11, 0
SSD_2:
    ds_read_b128 v[84:87], v144 offset:0
    ds_read_b128 v[88:91], v144 offset:64
    ds_read_b128 v[92:95], v144 offset:128
    ds_read_b128 v[96:99], v144 offset:192
    ds_read_b64_tr_b16 v[16:17], v165 offset:0
    ds_read_b64_tr_b16 v[18:19], v165 offset:512
    ds_read_b64_tr_b16 v[20:21], v165 offset:4096
    ds_read_b64_tr_b16 v[22:23], v165 offset:4608
    ds_read_b64_tr_b16 v[24:25], v165 offset:8192
    ds_read_b64_tr_b16 v[26:27], v165 offset:8704
    ds_read_b64_tr_b16 v[28:29], v165 offset:12288
    ds_read_b64_tr_b16 v[30:31], v165 offset:12800
    v_lshlrev_b32 v4, 3, v2
    v_add_u32 v4, 73808, v4
    ds_read_b64 v[6:7], v4
    v_mov_b32 v4, 73840
    ds_read_b64 v[12:13], v4
    v_mov_b32 v100, 0x3f803f80
    v_mov_b32 v101, 0x3f803f80
    v_mov_b32 v102, 0x3f803f80
    v_mov_b32 v103, 0x3f803f80
    s_waitcnt lgkmcnt(0)
    v_mfma_f32_16x16x32_bf16 v[112:115], v[84:87], v[16:19], 0
    v_mfma_f32_16x16x32_bf16 v[116:119], v[100:103], v[16:19], 0
    v_mfma_f32_16x16x32_bf16 v[112:115], v[88:91], v[20:23], v[112:115]
    v_mfma_f32_16x16x32_bf16 v[116:119], v[100:103], v[20:23], v[116:119]
    v_mfma_f32_16x16x32_bf16 v[112:115], v[92:95], v[24:27], v[112:115]
    v_mfma_f32_16x16x32_bf16 v[116:119], v[100:103], v[24:27], v[116:119]
    v_mfma_f32_16x16x32_bf16 v[112:115], v[96:99], v[28:31], v[112:115]
    v_mfma_f32_16x16x32_bf16 v[116:119], v[100:103], v[28:31], v[116:119]
    s_nop 7
    v_fma_f32 v112, -v6, v116, v112
    v_mul_f32 v112, v112, v7
    v_mov_b32 v139, v116
    v_mov_b32 v113, v12
    s_lshl_b32 s12, s4, 16
    s_lshl_b32 s15, s6, 12
    s_add_u32 s12, s12, s15
    s_lshl_b32 s15, s7, 9
    s_add_u32 s12, s12, s15
    s_lshl_b32 s15, s45, 7
    s_add_u32 s12, s12, s15
    s_add_u32 s12, s12, 4194304
    v_lshlrev_b32 v4, 14, v2
    v_lshl_add_u32 v4, v1, 3, v4
    v_add_u32 v4, s12, v4
    global_store_dwordx2 v4, v[112:113], s[40:41] sc1
    v_readfirstlane_b32 s48, v12
    v_readfirstlane_b32 s49, v13
    s_cmp_lg_u32 s45, 1
    s_cbranch_scc1 S_NOREC
    s_lshl_b32 s12, s4, 9
    s_lshl_b32 s15, s5, 4
    s_add_u32 s12, s12, s15
    s_add_u32 s12, s12, 1933312
    v_mov_b32 v4, s12
    v_mov_b32 v14, s66
    s_mov_b64 exec, 1
    global_store_dwordx3 v4, v[12:14], s[40:41] sc1
    s_mov_b64 exec, -1
S_NOREC:
    s_lshl_b32 s12, s4, 16
    s_lshl_b32 s15, s6, 14
    s_add_u32 s12, s12, s15
    s_lshl_b32 s15, s45, 10
    s_add_u32 s12, s12, s15
    s_add_u32 s12, s12, 4198400
    v_add_u32 v4, s12, v3
    v_add_u32 v5, 8192, v4
    s_lshl_b32 s12, s45, 10
    s_add_u32 s12, s12, 1933312
    v_lshlrev_b32 v6, 4, v0
    v_add_u32 v6, s12, v6
    s_sleep 64
    s_mov_b64 s[70:71], -1
S_AG0:
    global_load_dwordx4 v[84:87], v4, s[40:41] offset:-4096 sc1
    global_load_dwordx4 v[88:91], v4, s[40:41] sc1
    global_load_dwordx4 v[92:95], v5, s[40:41] offset:-4096 sc1
    global_load_dwordx4 v[96:99], v5, s[40:41] sc1
    s_sub_u32 s11, s11, 1
    s_cbranch_scc1 S_AG0_X
    s_waitcnt vmcnt(0)
    v_cmpx_eq_u32 vcc, s48, v85
    v_cmpx_eq_u32 vcc, s48, v87
    v_cmpx_eq_u32 vcc, s48, v89
    v_cmpx_eq_u32 vcc, s48, v91
    v_cmpx_eq_u32 vcc, s48, v93
    v_cmpx_eq_u32 vcc, s48, v95
    v_cmpx_eq_u32 vcc, s48, v97
    v_cmpx_eq_u32 vcc, s48, v99
    s_nop 0
    s_andn2_b64 s[70:71], s[70:71], exec
    s_mov_b64 exec, s[70:71]
    s_cbranch_scc1 S_AG0
S_AG0_DONE:
    s_mov_b64 exec, -1
    global_load_dwordx3 v[12:14], v6, s[40:41] sc1
    v_add_f32 v84, v84, v88
    v_add_f32 v92, v92, v96
    v_add_f32 v84, v84, v92
    v_add_f32 v86, v86, v90
    v_add_f32 v94, v94, v98
    v_add_f32 v86, v86, v94
    v_cvt_pk_bf16_f32 v120, v84, v86
    s_mul_i32 s12, s45, 320
    s_add_u32 s12, s12, 70208
    v_lshlrev_b32 v4, 2, v0
    v_add_u32 v4, s12, v4
    ds_write_b32 v4, v120
    s_waitcnt lgkmcnt(0)
    s_barrier
    v_lshrrev_b32 v4, 3, v0
    v_and_b32 v5, 7, v0
    v_lshlrev_b32 v138, 10, v4
    v_lshl_add_u32 v138, v5, 4, v138
    s_lshl_b32 s12, s4, 19
    s_lshl_b32 s15, s6, 17
    s_add_u32 s12, s12, s15
    s_lshl_b32 s15, s45, 15
    s_add_u32 s12, s12, s15
    s_lshl_b32 s15, s7, 7
    s_add_u32 s12, s12, s15
    s_add_u32 s62, s24, s12
    s_addc_u32 s63, s25, 0
    s_lshl_b32 s13, s45, 12
    s_add_u32 s13, s13, 16384
    s_add_u32 m0, s13, 0
    s_nop 0
    global_load_lds_dwordx4 v138, s[62:63]
    s_add_u32 s62, s62, 8192
    s_addc_u32 s63, s63, 0
    s_add_u32 m0, s13, 1024
    s_nop 0
    global_load_lds_dwordx4 v138, s[62:63]
    s_add_u32 s62, s62, 8192
    s_addc_u32 s63, s63, 0
    s_add_u32 m0, s13, 2048
    s_nop 0
    global_load_lds_dwordx4 v138, s[62:63]
    s_add_u32 s62, s62, 8192
    s_addc_u32 s63, s63, 0
    s_add_u32 m0, s13, 3072
    s_nop 0
    global_load_lds_dwordx4 v138, s[62:63]
    s_mul_i32 s12, s8, 114688
    s_mul_i32 s15, s4, 448
    s_add_u32 s12, s12, s15
    s_mul_i32 s15, s9, 224
    s_add_u32 s12, s12, s15
    s_add_u32 s62, s28, s12
    s_addc_u32 s63, s29, 0
    s_lshl_b32 s13, s45, 1
    s_lshl_b32 s12, s13, 6
    v_add_u32 v4, s12, v0
    v_mul_u32_u24 v5, 4682, v4
    v_lshrrev_b32 v5, 16, v5
    v_mul_u32_u24 v7, 14, v5
    v_sub_u32 v4, v4, v7
    v_mul_u32_u24 v5, 3584, v5
    v_lshl_add_u32 v4, v4, 4, v5
    s_lshl_b32 s12, s13, 10
    s_add_u32 m0, s12, 61440
    s_nop 0
    global_load_lds_dwordx4 v4, s[62:63]
    s_lshl_b32 s13, s45, 1
    s_add_u32 s13, s13, 1
    s_min_u32 s13, s13, 6
    s_lshl_b32 s12, s13, 6
    v_add_u32 v4, s12, v0
    v_mul_u32_u24 v5, 4682, v4
    v_lshrrev_b32 v5, 16, v5
    v_mul_u32_u24 v7, 14, v5
    v_sub_u32 v4, v4, v7
    v_mul_u32_u24 v5, 3584, v5
    v_lshl_add_u32 v4, v4, 4, v5
    s_lshl_b32 s12, s13, 10
    s_add_u32 m0, s12, 61440
    s_nop 0
    global_load_lds_dwordx4 v4, s[62:63]
    s_waitcnt vmcnt(6)
    s_branch S_RP_CHK
S_RP:
    global_load_dwordx3 v[12:14], v6, s[40:41] sc1
    s_waitcnt vmcnt(0)
S_RP_CHK:
    v_cmp_ne_u64 vcc, s[48:49], v[12:13]
    s_nop 0
    s_cbranch_vccz S_RP_DONE
    s_sleep 8
    s_sub_u32 s11, s11, 1
    s_cbranch_scc0 S_RP
    s_mov_b32 s11, 0
    v_mov_b32 v14, -1
S_RP_DONE:
    s_lshr_b32 s12, s4, 1
    s_cmp_lg_u32 s12, s45
    s_cbranch_scc1 S_REC_SKIP
    v_cmp_ne_u32 vcc, s66, v14
    s_bitcmp1_b32 s4, 0
    s_cselect_b32 s12, vcc_hi, vcc_lo
    s_cmp_eq_u32 s12, 0
    s_cselect_b32 s12, 1, 0
    v_mov_b32 v5, 73792
    v_mov_b32 v7, s12
    ds_write_b32 v5, v7
S_REC_SKIP:
    global_load_dwordx4 v[140:143], v166, s[72:73] sc1
    s_mov_b32 exec_lo, 0xffffffff
    s_mov_b32 exec_hi, 0x00000000
    global_load_dwordx4 v[140:143], v166, s[72:73] offset:1024 sc1
    s_mov_b64 exec, -1
    s_mul_i32 s12, s4, 229376
    s_lshl_b32 s15, s7, 7
    s_add_u32 s12, s12, s15
    s_mul_i32 s15, s45, 57344
    s_add_u32 s12, s12, s15
    s_add_u32 s62, s32, s12
    s_addc_u32 s63, s33, 0
    s_mul_i32 s13, s45, 7168
    s_add_u32 s13, s13, 32768
    s_add_u32 m0, s13, 0
    s_nop 0
    global_load_lds_dwordx4 v138, s[62:63]
    s_add_u32 s62, s62, 8192
    s_addc_u32 s63, s63, 0
    s_add_u32 m0, s13, 1024
    s_nop 0
    global_load_lds_dwordx4 v138, s[62:63]
    s_add_u32 s62, s62, 8192
    s_addc_u32 s63, s63, 0
    s_add_u32 m0, s13, 2048
    s_nop 0
    global_load_lds_dwordx4 v138, s[62:63]
    s_and_b32 s12, s5, 3
    s_min_u32 s12, s12, 2
    s_lshl_b32 s12, s12, 12
    s_lshl_b32 s15, s45, 10
    s_add_u32 s12, s12, s15
    v_add_u32 v7, s12, v3
    global_load_dwordx4 v[140:143], v7, s[46:47] offset:-4
    s_waitcnt lgkmcnt(0)
S_LOOP:
    s_barrier
    v_mov_b32 v5, 73792
    ds_read_b32 v6, v5
    ds_read_b128 v[84:87], v158
    ds_read_b128 v[88:91], v158 offset:16
    ds_read_b128 v[92:95], v157 offset:0
    ds_read_b128 v[96:99], v157 offset:2304
    ds_read_b128 v[100:103], v157 offset:4608
    ds_read_b128 v[104:107], v157 offset:6912
    v_mov_b32 v123, s60
    s_waitcnt lgkmcnt(4)
    v_readfirstlane_b32 s44, v6
    v_max3_f32 v120, v84, v86, v88
    v_max_f32 v120, v120, v90
    v_mov_b32 v122, v120
    s_nop 1
    v_permlane32_swap_b32 v120, v122
    v_max_f32 v120, v120, v122
    v_sub_f32 v84, v84, v120
    v_sub_f32 v86, v86, v120
    v_sub_f32 v88, v88, v120
    v_sub_f32 v90, v90, v120
    v_exp_f32 v84, v84
    v_exp_f32 v86, v86
    v_exp_f32 v88, v88
    v_exp_f32 v90, v90
    s_waitcnt lgkmcnt(0)
    v_pk_mul_f32 v[112:113], v[84:85], v[92:93] op_sel_hi:[0,1]
    v_pk_mul_f32 v[114:115], v[84:85], v[94:95] op_sel_hi:[0,1]
    v_mul_f32 v121, v84, v85
    v_pk_fma_f32 v[112:113], v[86:87], v[96:97], v[112:113] op_sel_hi:[0,1,1]
    v_pk_fma_f32 v[114:115], v[86:87], v[98:99], v[114:115] op_sel_hi:[0,1,1]
    v_fmac_f32 v121, v86, v87
    v_pk_fma_f32 v[112:113], v[88:89], v[100:101], v[112:113] op_sel_hi:[0,1,1]
    v_pk_fma_f32 v[114:115], v[88:89], v[102:103], v[114:115] op_sel_hi:[0,1,1]
    v_fmac_f32 v121, v88, v89
    v_pk_fma_f32 v[112:113], v[90:91], v[104:105], v[112:113] op_sel_hi:[0,1,1]
    v_pk_fma_f32 v[114:115], v[90:91], v[106:107], v[114:115] op_sel_hi:[0,1,1]
    v_fmac_f32 v121, v90, v91
    v_mov_b32 v122, v121
    v_permlane32_swap_b32 v112, v114
    v_permlane32_swap_b32 v113, v115
    v_permlane32_swap_b32 v121, v122
    v_add_f32 v112, v112, v114
    v_add_f32 v113, v113, v115
    v_add_f32 v121, v121, v122
    s_cmp_eq_u32 s44, 0
    s_cbranch_scc1 SAFE_3
    global_store_dwordx2 v159, v[112:113], s[72:73]
    s_mov_b64 exec, 1
    global_store_dwordx2 v123, v[120:121], s[72:73]
    s_mov_b64 exec, -1
SEND_4:
    s_barrier
    s_cmp_lg_u32 s10, 0
    s_cbranch_scc1 NOTL0_5
    v_add_u32 v128, 32768, v150
    v_add_u32 v129, 4294881280, v161
    v_mov_b32 v84, 0x3f803f80
    v_mov_b32 v85, 0x3f803f80
    v_mov_b32 v86, 0x3f803f80
    v_mov_b32 v87, 0x3f803f80
    s_waitcnt vmcnt(8)
    v_mov_b32 v5, 73800
    v_mov_b32 v6, 1
    s_mov_b64 exec, 1
    ds_add_u32 v5, v6
    s_mov_b64 exec, -1
SSY_6:
    ds_read_b32 v6, v5
    s_waitcnt lgkmcnt(0)
    v_readfirstlane_b32 s12, v6
    s_nop 0
    s_cmp_eq_u32 s12, 4
    s_cbranch_scc1 SSD_7
    s_sub_u32 s11, s11, 1
    s_cbranch_scc0 SSY_6
    s_mov_b32 s11, 0
SSD_7:
    ds_read_b64_tr_b16 v[48:49], v167 offset:61440
    ds_read_b64_tr_b16 v[50:51], v167 offset:62336
    ds_read_b64_tr_b16 v[52:53], v167 offset:61472
    ds_read_b64_tr_b16 v[54:55], v167 offset:62368
    ds_read_b64_tr_b16 v[32:33], v165 offset:16384
    ds_read_b64_tr_b16 v[34:35], v165 offset:16896
    ds_read_b64_tr_b16 v[36:37], v165 offset:20480
    ds_read_b64_tr_b16 v[38:39], v165 offset:20992
    ds_read_b64_tr_b16 v[40:41], v165 offset:24576
    ds_read_b64_tr_b16 v[42:43], v165 offset:25088
    ds_read_b64_tr_b16 v[44:45], v165 offset:28672
    ds_read_b64_tr_b16 v[46:47], v165 offset:29184
    s_waitcnt lgkmcnt(8)
    v_mfma_f32_16x16x32_bf16 v[116:119], v[84:87], v[48:51], 0
    v_mfma_f32_16x16x32_bf16 v[88:91], v[84:87], v[52:55], 0
    s_cmp_eq_u32 s45, 3
    s_cselect_b32 s12, 0, 0xffff
    s_cmp_eq_u32 s44, 0
    s_cbranch_scc1 SAFE_8
    s_mov_b32 exec_lo, 0x0000ffff
    s_mov_b32 exec_hi, 0x00000000
    global_store_dword v128, v139, s[72:73]
    global_store_dword v129, v116, s[72:73]
    s_mov_b32 exec_lo, s12
    global_store_dword v129, v88, s[72:73] offset:64
    s_mov_b64 exec, -1
SEND_9:
    s_waitcnt lgkmcnt(0)
NOTL0_5:
    s_barrier
    ds_read_b128 v[84:87], v146 offset:0
    ds_read_b128 v[88:91], v146 offset:64
    ds_read_b128 v[92:95], v146 offset:128
    ds_read_b128 v[96:99], v146 offset:192
    s_waitcnt lgkmcnt(3)
    v_mfma_f32_16x16x32_bf16 v[112:115], v[84:87], v[32:35], 0
    s_waitcnt lgkmcnt(2)
    v_mfma_f32_16x16x32_bf16 v[112:115], v[88:91], v[36:39], v[112:115]
    s_waitcnt lgkmcnt(1)
    v_mfma_f32_16x16x32_bf16 v[112:115], v[92:95], v[40:43], v[112:115]
    s_waitcnt lgkmcnt(0)
    v_mfma_f32_16x16x32_bf16 v[112:115], v[96:99], v[44:47], v[112:115]
    s_nop 7
    v_cvt_pk_bf16_f32 v112, v112, v112
    global_store_short v160, v112, s[42:43] sc1
    s_barrier
    s_cmp_lg_u32 s10, 0
    s_cbranch_scc1 NOTL0_10
    s_mul_i32 s12, s4, 229376
    s_lshl_b32 s15, s7, 7
    s_add_u32 s12, s12, s15
    s_mul_i32 s15, s45, 57344
    s_add_u32 s12, s12, s15
    s_add_u32 s12, s12, 24576
    s_add_u32 s62, s32, s12
    s_addc_u32 s63, s33, 0
    s_mul_i32 s13, s45, 7168
    s_add_u32 s13, s13, 32768
    s_add_u32 m0, s13, 3072
    s_nop 0
    global_load_lds_dwordx4 v138, s[62:63]
    s_add_u32 s62, s62, 8192
    s_addc_u32 s63, s63, 0
    s_add_u32 m0, s13, 4096
    s_nop 0
    global_load_lds_dwordx4 v138, s[62:63]
    s_add_u32 s62, s62, 8192
    s_addc_u32 s63, s63, 0
    s_add_u32 m0, s13, 5120
    s_nop 0
    global_load_lds_dwordx4 v138, s[62:63]
    s_add_u32 s62, s62, 8192
    s_addc_u32 s63, s63, 0
    s_add_u32 m0, s13, 6144
    s_nop 0
    global_load_lds_dwordx4 v138, s[62:63]
    s_sub_u32 s12, 4, s6
    s_lshl_b32 s12, s12, 13
    v_add_u32 v128, s12, v152
POLL_11:
    global_load_dwordx4 v[120:123], v128, s[72:73] sc1
    global_load_dwordx4 v[124:127], v128, s[72:73] offset:2048 sc1
    s_waitcnt vmcnt(0)
    v_cmp_u_f32 vcc, v120, v124
    v_cmp_u_f32 s[70:71], v121, v125
    s_nop 0
    s_or_b64 vcc, vcc, s[70:71]
    v_cmp_u_f32 s[70:71], v122, v126
    s_nop 0
    s_or_b64 vcc, vcc, s[70:71]
    v_cmp_u_f32 s[70:71], v123, v127
    s_nop 0
    s_or_b64 vcc, vcc, s[70:71]
    s_cbranch_vccz PDONE_12
    s_sleep 4
    s_sub_u32 s11, s11, 1
    s_cbranch_scc0 POLL_11
    s_mov_b32 s11, 0
PDONE_12:
    v_add_f32 v120, v120, v124
    v_add_f32 v121, v121, v125
    v_add_f32 v122, v122, v126
    v_add_f32 v123, v123, v127
    s_nop 0
    v_permlane32_swap_b32 v120, v122
    v_permlane32_swap_b32 v121, v123
    v_add_f32 v120, v120, v122
    v_add_f32 v121, v121, v123
    v_mov_b32 v155, v120
    v_mov_b32 v156, v121
NOTL0_10:
    s_barrier
    ds_read_b128 v[84:87], v147
    s_cmp_eq_u32 s45, 3
    s_cbranch_scc1 S_W1_W3
    s_waitcnt lgkmcnt(0)
    v_mfma_f32_16x16x32_bf16 v[112:115], v[84:87], v[48:51], 0
    v_mfma_f32_16x16x32_bf16 v[116:119], v[84:87], v[52:55], 0
    s_cmp_eq_u32 s44, 0
    s_cbranch_scc1 SAFE_13
    s_nop 4
    global_store_dword v161, v112, s[72:73]
    global_store_dword v161, v116, s[72:73] offset:64
SEND_14:
    s_branch S_W1_DONE
S_W1_W3:
    ds_read_b128 v[88:91], v148
    s_waitcnt lgkmcnt(1)
    v_mfma_f32_16x16x32_bf16 v[112:115], v[84:87], v[48:51], 0
    s_waitcnt lgkmcnt(0)
    v_mfma_f32_16x16x32_bf16 v[116:119], v[84:87], v[88:91], 0
    s_cmp_eq_u32 s44, 0
    s_cbranch_scc1 SAFE_15
    s_nop 3
    global_store_dword v161, v112, s[72:73]
    s_mov_b32 exec_lo, 0x00120011
    s_mov_b32 exec_hi, 0x00180014
    global_store_dword v162, v116, s[72:73]
    s_mov_b32 exec_lo, 0x000f000f
    s_mov_b32 exec_hi, 0x000f000f
    global_store_dwordx4 v163, v[88:91], s[72:73]
    s_mov_b64 exec, -1
SEND_16:
S_W1_DONE:
    s_barrier
    s_cmp_lg_u32 s10, 0
    s_cbranch_scc1 NOTL0_17
    ds_read_b64_tr_b16 v[56:57], v165 offset:32768
    ds_read_b64_tr_b16 v[58:59], v165 offset:33280
    ds_read_b64_tr_b16 v[60:61], v165 offset:36864
    ds_read_b64_tr_b16 v[62:63], v165 offset:37376
    ds_read_b64_tr_b16 v[64:65], v165 offset:40960
    ds_read_b64_tr_b16 v[66:67], v165 offset:41472
    ds_read_b64_tr_b16 v[68:69], v165 offset:45056
    ds_read_b64_tr_b16 v[70:71], v165 offset:45568
    ds_read_b64_tr_b16 v[72:73], v165 offset:49152
    ds_read_b64_tr_b16 v[74:75], v165 offset:49664
    ds_read_b64_tr_b16 v[76:77], v165 offset:53248
    ds_read_b64_tr_b16 v[78:79], v165 offset:53760
    ds_read_b64_tr_b16 v[80:81], v165 offset:57344
    ds_read_b64_tr_b16 v[82:83], v165 offset:57856
    s_waitcnt lgkmcnt(0)
NOTL0_17:
    s_barrier
    ds_read_b128 v[84:87], v149 offset:0
    ds_read_b128 v[88:91], v149 offset:64
    ds_read_b128 v[92:95], v149 offset:128
    ds_read_b128 v[96:99], v149 offset:192
    ds_read_b128 v[100:103], v149 offset:256
    ds_read_b128 v[104:107], v149 offset:320
    ds_read_b128 v[108:111], v149 offset:384
    s_waitcnt lgkmcnt(6)
    v_mfma_f32_16x16x32_bf16 v[112:115], v[84:87], v[56:59], 0
    s_waitcnt lgkmcnt(5)
    v_mfma_f32_16x16x32_bf16 v[112:115], v[88:91], v[60:63], v[112:115]
    s_waitcnt lgkmcnt(4)
    v_mfma_f32_16x16x32_bf16 v[112:115], v[92:95], v[64:67], v[112:115]
    s_waitcnt lgkmcnt(3)
    v_mfma_f32_16x16x32_bf16 v[112:115], v[96:99], v[68:71], v[112:115]
    s_waitcnt lgkmcnt(2)
    v_mfma_f32_16x16x32_bf16 v[112:115], v[100:103], v[72:75], v[112:115]
    s_waitcnt lgkmcnt(1)
    v_mfma_f32_16x16x32_bf16 v[112:115], v[104:107], v[76:79], v[112:115]
    s_waitcnt lgkmcnt(0)
    v_mfma_f32_16x16x32_bf16 v[112:115], v[108:111], v[80:83], v[112:115]
    s_mov_b32 exec_lo, 0x0000ffff
    s_mov_b32 exec_hi, 0x00000000
    s_nop 5
    global_store_dword v164, v112, s[42:43] sc1
    s_mov_b64 exec, -1
    s_barrier
    s_cmp_lg_u32 s10, 0
    s_cbranch_scc1 L_EXIT
    s_mov_b32 s10, 1
    s_add_u32 s42, s42, 2097152
    s_addc_u32 s43, s43, 0
    s_mul_i32 s12, s5, 2176
    s_mul_i32 s15, s45, 544
    s_add_u32 s12, s12, s15
    s_add_u32 s12, s12, 61440
    v_add_u32 v4, s12, v3
    s_cmp_eq_u32 s44, 0
    s_cbranch_scc1 SAFE_18
    s_mov_b32 exec_lo, 0xffffffff
    s_mov_b32 exec_hi, 0x00000003
    global_store_dwordx4 v4, v[8:11], s[72:73]
    s_mov_b64 exec, -1
SEND_19:
    s_lshl_b32 s12, s45, 6
    v_add_u32 v120, s12, v144
    v_mov_b32 v128, 0
    s_waitcnt vmcnt(0)
    s_barrier
    ds_read_b128 v[84:87], v144 offset:0
    ds_read_b128 v[88:91], v144 offset:64
    ds_read_b128 v[92:95], v144 offset:128
    ds_read_b128 v[96:99], v144 offset:192
    ds_read_b128 v[100:103], v145
    ds_read_b128 v[104:107], v120
    s_waitcnt lgkmcnt(5)
    v_mfma_f32_16x16x32_bf16 v[112:115], v[84:87], v[16:19], 0
    s_waitcnt lgkmcnt(4)
    v_mfma_f32_16x16x32_bf16 v[112:115], v[88:91], v[20:23], v[112:115]
    s_waitcnt lgkmcnt(3)
    v_mfma_f32_16x16x32_bf16 v[112:115], v[92:95], v[24:27], v[112:115]
    s_waitcnt lgkmcnt(2)
    v_mfma_f32_16x16x32_bf16 v[112:115], v[96:99], v[28:31], v[112:115]
    s_waitcnt lgkmcnt(0)
    v_mfma_f32_16x16x32_bf16 v[116:119], v[104:107], v[100:103], 0
    s_cmp_eq_u32 s44, 0
    s_cbranch_scc1 SAFE_20
    s_nop 3
    global_store_dword v150, v112, s[72:73]
    s_mov_b32 exec_lo, 0x00120011
    s_mov_b32 exec_hi, 0x00180014
    global_store_dword v151, v116, s[72:73]
    s_mov_b64 exec, -1
SEND_21:
    s_mov_b32 s64, 0xffffffff
    s_mov_b32 s65, 0x00000000
    s_mov_b64 s[70:71], -1
OP_22:
    s_and_b64 exec, s[70:71], s[64:65]
    global_load_dword v128, v153, s[72:73] sc1
    s_mov_b64 exec, s[70:71]
    global_load_dwordx4 v[120:123], v152, s[72:73] sc1
    global_load_dwordx4 v[124:127], v152, s[72:73] offset:2048 sc1
    s_sub_u32 s11, s11, 1
    s_cbranch_scc1 OP_22_X
    s_waitcnt vmcnt(0)
    v_cmpx_o_f32 vcc, v120, v121
    v_cmpx_o_f32 vcc, v122, v123
    v_cmpx_o_f32 vcc, v124, v125
    v_cmpx_o_f32 vcc, v126, v127
    v_cmpx_o_f32 vcc, v128, v128
    s_nop 0
    s_andn2_b64 s[70:71], s[70:71], exec
    s_mov_b64 exec, s[70:71]
    s_cbranch_scc1 OP_22
OPD_23:
    s_mov_b64 exec, -1
    v_add_f32_dpp v88, v128, v128 quad_perm:[1,0,3,2] row_mask:0xf bank_mask:0xf
    s_nop 1
    v_add_f32_dpp v88, v88, v88 quad_perm:[2,3,0,1] row_mask:0xf bank_mask:0xf
    v_add_f32 v84, v120, v124
    s_nop 0
    v_add_f32_dpp v88, v88, v88 row_half_mirror row_mask:0xf bank_mask:0xf
    v_add_f32 v85, v121, v125
    s_nop 0
    v_add_f32_dpp v88, v88, v88 row_mirror row_mask:0xf bank_mask:0xf
    s_nop 0
    v_readlane_b32 s12, v88, 0
    v_add_f32 v86, v122, v126
    v_readlane_b32 s13, v88, 16
    v_add_f32 v87, v123, v127
    v_mov_b32 v90, 0x3b000000
    v_mov_b32 v91, 0x3727c5ac
    v_permlane32_swap_b32 v84, v86
    v_mul_f32 v89, s12, v90
    v_permlane32_swap_b32 v85, v87
    v_mul_f32 v88, s13, v90
    v_fma_f32 v88, -v89, v89, v88
    v_add_f32 v84, v84, v86
    v_add_f32 v88, abs(v88), v91
    v_add_f32 v85, v85, v87
    v_rsq_f32 v88, v88
    s_nop 0
    v_mul_f32 v89, v89, v88
    v_mul_f32 v6, v89, v155
    v_mul_f32 v7, v89, v156
    v_fma_f32 v4, v84, v88, -v6
    v_fma_f32 v5, v85, v88, -v7
    v_cvt_pk_bf16_f32 v4, v4, v5
    ds_write_b32 v154, v4
    s_waitcnt lgkmcnt(0)
    s_barrier
    s_lshl_b32 s12, s5, 11
    s_lshl_b32 s15, s45, 9
    s_add_u32 s12, s12, s15
    s_add_u32 s12, s12, 131072
    v_add_u32 v4, s12, v3
    s_cmp_eq_u32 s44, 0
    s_cbranch_scc1 SAFE_24
    s_mov_b32 exec_lo, 0xffffffff
    s_mov_b32 exec_hi, 0x00000000
    global_store_dwordx4 v4, v[8:11], s[72:73]
    s_mov_b64 exec, -1
SEND_25:
    s_waitcnt vmcnt(0)
    s_branch S_LOOP
L_G:
    s_lshr_b32 s66, s4, 1
    s_and_b32 s13, s6, 1
    s_lshl_b32 s13, s13, 2
    s_or_b32 s66, s66, s13
    s_lshl_b32 s13, s6, 1
    s_xor_b32 s13, s13, s3
    s_lshl_b32 s12, s6, 24
    s_lshl_b32 s15, s4, 21
    s_add_u32 s12, s12, s15
    s_lshl_b32 s15, s7, 10
    s_add_u32 s12, s12, s15
    s_lshl_b32 s15, s13, 13
    s_add_u32 s12, s12, s15
    s_add_u32 s12, s12, 1572864
    v_and_b32 v8, 3, v1
    v_lshrrev_b32 v9, 2, v1
    s_and_b32 s13, s66, 3
    v_xor_b32 v10, s13, v8
    v_lshlrev_b32 v10, 16, v10
    v_lshl_add_u32 v10, v9, 8, v10
    v_lshl_add_u32 v10, v2, 4, v10
    s_lshr_b32 s14, s66, 2
    s_mul_i32 s14, s14, 262144
    v_mov_b32 v129, 73804
    s_waitcnt lgkmcnt(0)
    s_add_u32 s64, s20, s12
    s_addc_u32 s65, s21, 0
    s_add_u32 s26, s18, s12
    s_addc_u32 s27, s19, 0
    s_add_u32 s62, s26, s14
    s_addc_u32 s63, s27, 0
    s_xor_b32 s77, s14, 262144
    s_barrier
    global_load_dwordx4 v[16:19], v10, s[62:63] offset:0
    global_load_dwordx4 v[20:23], v10, s[62:63] offset:64
    global_load_dwordx4 v[24:27], v10, s[62:63] offset:128
    global_load_dwordx4 v[28:31], v10, s[62:63] offset:192
    s_add_u32 s62, s26, s77
    s_addc_u32 s63, s27, 0
    v_mov_b32 v128, v10
    v_lshrrev_b32 v11, 3, v0
    v_and_b32 v12, 7, v0
    v_lshlrev_b32 v167, 10, v11
    v_lshl_add_u32 v167, v12, 4, v167
    s_lshr_b32 s67, s3, 1
    s_and_b32 s68, s3, 1
    s_min_u32 s69, s3, 6
    v_lshlrev_b32 v13, 2, v1
    v_lshl_add_u32 v13, v2, 0, v13
    s_lshl_b32 s12, s6, 8
    s_lshl_b32 s15, s68, 7
    s_add_u32 s12, s12, s15
    v_lshlrev_b32 v14, 1, v13
    v_add_u32 v14, s12, v14
    global_load_ushort v161, v14, s[34:35]
    v_lshlrev_b32 v10, 2, v12
    v_lshl_add_u32 v10, v2, 0, v10
    s_lshl_b32 s12, s69, 6
    v_lshlrev_b32 v10, 1, v10
    v_add_u32 v10, s12, v10
    s_mul_i32 s12, s4, 448
    v_add_u32 v6, s12, v10
    global_load_ushort v160, v6, s[30:31]
    s_mov_b32 s50, 0x000f000f
    s_mov_b32 s51, 0x000f000f
    s_mov_b32 s52, 0x00f000f0
    s_mov_b32 s53, 0x00f000f0
    s_mov_b32 s54, 0x0f000f00
    s_mov_b32 s55, 0x0f000f00
    s_mov_b32 s56, 0xf000f000
    s_mov_b32 s57, 0xf000f000
    s_mov_b32 s58, 0x05040100
    s_mov_b32 s59, 0x07060302
    s_mov_b32 s60, 0x3e0293ee
    s_mov_b32 s42, s40
    s_mov_b32 s43, s41
    s_mul_i32 s12, s4, 196608
    s_add_u32 s72, s40, s12
    s_addc_u32 s73, s41, 0
    v_add_u32 v156, 73088, v10
    s_lshl_b32 s12, s6, 14
    s_lshl_b32 s15, s67, 12
    s_add_u32 s12, s12, s15
    s_lshl_b32 s15, s68, 8
    s_add_u32 s12, s12, s15
    s_add_u32 s12, s12, 65536
    v_lshlrev_b32 v148, 10, v2
    v_lshl_add_u32 v148, v1, 4, v148
    v_add_u32 v148, s12, v148
    s_lshl_b32 s12, s6, 8
    s_lshl_b32 s15, s67, 6
    s_add_u32 s12, s12, s15
    s_add_u32 s12, s12, 61440
    v_lshlrev_b32 v149, 4, v2
    v_add_u32 v149, s12, v149
    v_lshrrev_b32 v4, 1, v2
    v_lshl_add_u32 v4, v1, 1, v4
    v_bfe_u32 v5, v4, 4, 1
    v_bfe_u32 v6, v4, 2, 2
    v_and_b32 v7, 3, v4
    v_and_b32 v4, 1, v2
    s_mul_i32 s12, s67, 320
    s_lshl_b32 s15, s68, 5
    s_add_u32 s12, s12, s15
    s_add_u32 s12, s12, 71488
    v_lshlrev_b32 v150, 6, v6
    v_lshl_add_u32 v150, v4, 4, v150
    v_lshl_add_u32 v150, v5, 3, v150
    v_lshl_add_u32 v150, v7, 1, v150
    v_add_u32 v150, s12, v150
    v_lshrrev_b32 v4, 2, v0
    v_and_b32 v5, 3, v0
    s_lshl_b32 s12, s8, 13
    s_lshl_b32 s15, s3, 10
    s_add_u32 s12, s12, s15
    s_add_u32 s12, s12, 1572864
    v_add_u32 v151, s12, v3
    s_lshr_b32 s13, s3, 2
    s_and_b32 s14, s3, 3
    v_and_b32 v4, 1, v0
    v_bfe_u32 v5, v0, 5, 1
    v_bfe_u32 v6, v0, 4, 1
    v_bfe_u32 v7, v0, 3, 1
    v_lshlrev_b32 v4, 4, v4
    v_lshl_add_u32 v4, v5, 3, v4
    v_lshl_add_u32 v4, v6, 2, v4
    v_lshl_add_u32 v6, v7, 1, v4
    s_mov_b32 s61, 0x00003f80
    s_mov_b32 s46, 0x3f800000
    s_mov_b32 s47, 0x3f803f80
    s_mov_b32 s48, 0xff00ff00
    s_mov_b32 s49, 0xff00ff00
    s_lshl_b32 s12, s14, 6
    s_lshl_b32 s15, s13, 5
    s_add_u32 s12, s12, s15
    s_add_u32 s12, s12, 72768
    v_add_u32 v153, s12, v6
    s_mul_i32 s12, s14, 320
    s_lshl_b32 s15, s13, 5
    s_add_u32 s12, s12, s15
    s_add_u32 s12, s12, 68608
    s_and_b32 s13, s8, 3
    s_lshl_b32 s13, s13, 6
    s_add_u32 s12, s12, s13
    v_add_u32 v152, s12, v6
    s_mul_i32 s12, s6, 14336
    s_lshl_b32 s15, s69, 7
    s_add_u32 s12, s12, s15
    s_add_u32 s12, s12, 131072
    v_mul_u32_u24 v154, 1792, v11
    v_lshl_add_u32 v154, v12, 4, v154
    v_add_u32 v154, s12, v154
    s_lshl_b32 s12, s6, 7
    s_add_u32 s12, s12, 193536
    v_lshlrev_b32 v155, 3, v1
    v_lshl_add_u32 v155, v2, 2, v155
    v_add_u32 v155, s12, v155
    s_lshl_b32 s12, s67, 14
    s_lshl_b32 s15, s6, 12
    s_add_u32 s12, s12, s15
    s_lshl_b32 s15, s68, 11
    s_add_u32 s12, s12, s15
    s_add_u32 s12, s12, 1835008
    v_lshlrev_b32 v157, 9, v2
    v_lshl_add_u32 v157, v1, 4, v157
    v_add_u32 v157, s12, v157
    s_lshl_b32 s12, s67, 10
    s_add_u32 s12, s12, 188416
    v_add_u32 v158, s12, v14
    s_lshl_b32 s12, s67, 10
    v_add_u32 v166, s12, v14
    s_mul_i32 s12, s67, 320
    s_lshl_b32 s15, s68, 7
    s_add_u32 s12, s12, s15
    s_add_u32 s12, s12, 68608
    v_lshlrev_b32 v159, 1, v13
    v_add_u32 v159, s12, v159
    v_mul_u32_u24 v163, 320, v8
    v_lshl_add_u32 v163, v2, 4, v163
    v_add_u32 v163, 70208, v163
    s_mul_i32 s12, s3, 2304
    s_add_u32 s12, s12, 74752
    v_mul_u32_u24 v164, 288, v8
    v_lshl_add_u32 v164, v2, 6, v164
    v_lshl_add_u32 v164, v9, 4, v164
    v_add_u32 v164, s12, v164
    s_lshl_b32 s12, s3, 3
    s_add_u32 s12, s12, 73536
    v_lshlrev_b32 v165, 6, v8
    v_add_u32 v165, s12, v165
    v_mov_b32 v10, v128
    global_load_dwordx4 v[32:35], v10, s[62:63] offset:0
    global_load_dwordx4 v[36:39], v10, s[62:63] offset:64
    global_load_dwordx4 v[40:43], v10, s[62:63] offset:128
    global_load_dwordx4 v[44:47], v10, s[62:63] offset:192
    s_xor_b32 s12, s66, 0
    s_mul_i32 s12, s12, 65536
    s_add_u32 s62, s64, s12
    s_addc_u32 s63, s65, 0
    global_load_dwordx4 v[48:51], v3, s[62:63]
    s_xor_b32 s12, s66, 1
    s_mul_i32 s12, s12, 65536
    s_add_u32 s62, s64, s12
    s_addc_u32 s63, s65, 0
    global_load_dwordx4 v[52:55], v3, s[62:63]
    s_xor_b32 s12, s66, 2
    s_mul_i32 s12, s12, 65536
    s_add_u32 s62, s64, s12
    s_addc_u32 s63, s65, 0
    global_load_dwordx4 v[56:59], v3, s[62:63]
    s_xor_b32 s12, s66, 3
    s_mul_i32 s12, s12, 65536
    s_add_u32 s62, s64, s12
    s_addc_u32 s63, s65, 0
    global_load_dwordx4 v[60:63], v3, s[62:63]
    s_xor_b32 s12, s66, 4
    s_mul_i32 s12, s12, 65536
    s_add_u32 s62, s64, s12
    s_addc_u32 s63, s65, 0
    global_load_dwordx4 v[64:67], v3, s[62:63]
    s_xor_b32 s12, s66, 5
    s_mul_i32 s12, s12, 65536
    s_add_u32 s62, s64, s12
    s_addc_u32 s63, s65, 0
    global_load_dwordx4 v[68:71], v3, s[62:63]
    s_xor_b32 s12, s66, 6
    s_mul_i32 s12, s12, 65536
    s_add_u32 s62, s64, s12
    s_addc_u32 s63, s65, 0
    global_load_dwordx4 v[72:75], v3, s[62:63]
    s_xor_b32 s12, s66, 7
    s_mul_i32 s12, s12, 65536
    s_add_u32 s62, s64, s12
    s_addc_u32 s63, s65, 0
    global_load_dwordx4 v[76:79], v3, s[62:63]
    v_cndmask_b32 v144, 0, -1, s[50:51]
    v_cndmask_b32 v145, 0, -1, s[52:53]
    v_cndmask_b32 v146, 0, -1, s[54:55]
    v_cndmask_b32 v147, 0, -1, s[56:57]
G_ENTRY:
    s_barrier
    ds_read_b128 v[112:115], v163 offset:0
    ds_read_b128 v[116:119], v163 offset:64
    ds_read_b128 v[120:123], v163 offset:128
    ds_read_b128 v[124:127], v163 offset:192
    s_waitcnt vmcnt(8)
    s_waitcnt lgkmcnt(3)
    v_mfma_f32_16x16x32_bf16 v[128:131], v[16:19], v[112:115], 0
    v_mfma_f32_16x16x32_bf16 v[132:135], v[32:35], v[112:115], 0
    s_waitcnt lgkmcnt(2)
    v_mfma_f32_16x16x32_bf16 v[128:131], v[20:23], v[116:119], v[128:131]
    v_mfma_f32_16x16x32_bf16 v[132:135], v[36:39], v[116:119], v[132:135]
    s_waitcnt lgkmcnt(1)
    v_mfma_f32_16x16x32_bf16 v[128:131], v[24:27], v[120:123], v[128:131]
    v_mfma_f32_16x16x32_bf16 v[132:135], v[40:43], v[120:123], v[132:135]
    s_waitcnt lgkmcnt(0)
    v_mfma_f32_16x16x32_bf16 v[128:131], v[28:31], v[124:127], v[128:131]
    v_mfma_f32_16x16x32_bf16 v[132:135], v[44:47], v[124:127], v[132:135]
    s_nop 6
    v_max3_f32 v136, v128, v129, v130
    v_max3_f32 v137, v132, v133, v134
    v_max3_f32 v136, v136, v131, v135
    v_max_f32 v136, v136, v137
    v_mov_b32 v137, v136
    s_nop 1
    v_permlane16_swap_b32 v136, v137
    v_max_f32 v136, v136, v137
    v_mov_b32 v137, v136
    s_nop 1
    v_permlane32_swap_b32 v136, v137
    v_max_f32 v136, v136, v137
    v_mul_f32 v138, s60, v136
    s_mov_b64 exec, s[50:51]
    v_fma_f32 v140, v128, s60, -v138
    v_fma_f32 v141, v129, s60, -v138
    s_mov_b64 exec, s[52:53]
    v_fma_f32 v140, v130, s60, -v138
    v_fma_f32 v141, v131, s60, -v138
    s_mov_b64 exec, s[54:55]
    v_fma_f32 v140, v132, s60, -v138
    v_fma_f32 v141, v133, s60, -v138
    s_mov_b64 exec, s[56:57]
    v_fma_f32 v140, v134, s60, -v138
    v_fma_f32 v141, v135, s60, -v138
    s_mov_b64 exec, -1
    v_exp_f32 v140, v140
    v_exp_f32 v141, v141
    s_nop 0
    v_cvt_pk_bf16_f32 v140, v140, v141
    s_cmp_eq_u32 s10, 0
    s_cbranch_scc1 VT_26
    v_and_b32 v112, v140, v144
    v_and_b32_dpp v113, v140, v144 row_ror:12 row_mask:0xf bank_mask:0xf
    v_and_b32_dpp v114, v140, v144 row_ror:8 row_mask:0xf bank_mask:0xf
    v_and_b32_dpp v115, v140, v144 row_ror:4 row_mask:0xf bank_mask:0xf
    v_and_b32_dpp v116, v140, v145 row_ror:4 row_mask:0xf bank_mask:0xf
    v_and_b32 v117, v140, v145
    v_mfma_f32_16x16x32_bf16 v[128:131], v[76:79], v[112:115], 0
    v_mfma_f32_16x16x32_bf16 v[4:7], v[80:83], v[112:115], 0
    v_and_b32_dpp v118, v140, v145 row_ror:12 row_mask:0xf bank_mask:0xf
    v_and_b32_dpp v119, v140, v145 row_ror:8 row_mask:0xf bank_mask:0xf
    v_mfma_f32_16x16x32_bf16 v[8:11], v[96:99], v[112:115], 0
    v_and_b32_dpp v120, v140, v146 row_ror:8 row_mask:0xf bank_mask:0xf
    v_and_b32_dpp v121, v140, v146 row_ror:4 row_mask:0xf bank_mask:0xf
    v_mfma_f32_16x16x32_bf16 v[4:7], v[84:87], v[116:119], v[4:7]
    v_and_b32 v122, v140, v146
    v_and_b32_dpp v123, v140, v146 row_ror:12 row_mask:0xf bank_mask:0xf
    v_mfma_f32_16x16x32_bf16 v[8:11], v[100:103], v[116:119], v[8:11]
    v_and_b32_dpp v124, v140, v147 row_ror:12 row_mask:0xf bank_mask:0xf
    v_and_b32_dpp v125, v140, v147 row_ror:8 row_mask:0xf bank_mask:0xf
    v_mfma_f32_16x16x32_bf16 v[4:7], v[88:91], v[120:123], v[4:7]
    v_and_b32_dpp v126, v140, v147 row_ror:4 row_mask:0xf bank_mask:0xf
    v_and_b32 v127, v140, v147
    v_mfma_f32_16x16x32_bf16 v[8:11], v[104:107], v[120:123], v[8:11]
    s_nop 0
    v_mfma_f32_16x16x32_bf16 v[4:7], v[92:95], v[124:127], v[4:7]
    v_mfma_f32_16x16x32_bf16 v[8:11], v[108:111], v[124:127], v[8:11]
VTD_27:
    v_mov_b32 v139, v128
    s_mov_b64 exec, s[50:51]
    ds_write_b64 v165, v[138:139]
    s_mov_b64 exec, -1
    s_nop 2
    ds_write_b128 v164, v[4:7]
    ds_write_b128 v164, v[8:11] offset:1152
    s_waitcnt lgkmcnt(0)
    s_barrier
    ds_read_u16 v63, v152
    v_mov_b32 v56, 0
    v_mov_b32 v57, 0
    v_mov_b32 v58, 0
    v_mov_b32 v59, 0
    s_barrier
    s_mov_b32 s64, 0x00010001
    s_mov_b32 s65, 0x00010001
    s_mov_b64 s[70:71], -1
OP_28:
    s_and_b64 exec, s[70:71], s[64:65]
    global_load_dwordx4 v[56:59], v149, s[72:73] sc1
    s_mov_b64 exec, s[70:71]
    global_load_dwordx4 v[48:51], v148, s[72:73] sc1
    global_load_dwordx4 v[52:55], v148, s[72:73] offset:512 sc1
    s_sub_u32 s11, s11, 1
    s_cbranch_scc1 OP_28_X
    s_waitcnt vmcnt(0)
    v_cmpx_o_f32 vcc, v48, v49
    v_cmpx_o_f32 vcc, v50, v51
    v_cmpx_o_f32 vcc, v52, v53
    v_cmpx_o_f32 vcc, v54, v55
    v_cmpx_o_f32 vcc, v56, v57
    v_cmpx_o_f32 vcc, v58, v59
    s_nop 0
    s_andn2_b64 s[70:71], s[70:71], exec
    s_mov_b64 exec, s[70:71]
    s_cbranch_scc1 OP_28
OPD_29:
    s_mov_b64 exec, -1
    v_max_f32 v60, v56, v58
    v_mov_b32 v61, v60
    s_nop 1
    v_permlane16_swap_b32 v60, v61
    v_max_f32 v60, v60, v61
    v_mov_b32 v61, v60
    s_nop 1
    v_permlane32_swap_b32 v60, v61
    v_max_f32 v60, v60, v61
    v_sub_f32 v68, v56, v60
    v_sub_f32 v69, v58, v60
    v_exp_f32 v68, v68
    v_exp_f32 v69, v69
    v_mul_f32 v61, v68, v57
    v_fmac_f32 v61, v69, v59
    v_mul_f32_dpp v64, v68, v48 row_newbcast:0 row_mask:0xf bank_mask:0xf
    v_mul_f32_dpp v65, v68, v49 row_newbcast:0 row_mask:0xf bank_mask:0xf
    v_mov_b32 v62, v61
    v_mul_f32_dpp v66, v68, v50 row_newbcast:0 row_mask:0xf bank_mask:0xf
    s_nop 0
    v_permlane16_swap_b32 v61, v62
    v_mul_f32_dpp v67, v68, v51 row_newbcast:0 row_mask:0xf bank_mask:0xf
    v_fmac_f32_dpp v64, v69, v52 row_newbcast:0 row_mask:0xf bank_mask:0xf
    v_add_f32 v61, v61, v62
    v_fmac_f32_dpp v65, v69, v53 row_newbcast:0 row_mask:0xf bank_mask:0xf
    v_mov_b32 v62, v61
    v_fmac_f32_dpp v66, v69, v54 row_newbcast:0 row_mask:0xf bank_mask:0xf
    v_fmac_f32_dpp v67, v69, v55 row_newbcast:0 row_mask:0xf bank_mask:0xf
    v_permlane32_swap_b32 v61, v62
    v_permlane16_swap_b32 v64, v65
    v_add_f32 v61, v61, v62
    v_permlane16_swap_b32 v66, v67
    v_rcp_f32 v61, v61
    v_add_f32 v64, v64, v65
    v_add_f32 v66, v66, v67
    s_nop 1
    v_permlane32_swap_b32 v64, v66
    v_add_f32 v60, v64, v66
    s_nop 1
    v_mul_f32_dpp v60, v61, v60 row_newbcast:0 row_mask:0xf bank_mask:0xf
    v_cvt_pk_bf16_f32 v60, v60, v60
    ds_write_b16 v150, v60
    s_waitcnt lgkmcnt(0)
    s_barrier
    v_lshlrev_b32 v63, 16, v63
    s_barrier
    s_cmp_eq_u32 s10, 0
    s_cbranch_scc1 G_CS1
    s_sleep 10
G_CS1_DONE:
    global_load_dwordx4 v[48:51], v151, s[42:43] sc1
W1B_CHK:
    s_waitcnt vmcnt(0)
    v_dot2_f32_bf16 v52, v48, s47, 0
    v_dot2_f32_bf16 v52, v49, s47, v52
    v_dot2_f32_bf16 v52, v50, s47, v52
    v_dot2_f32_bf16 v52, v51, s47, v52
    s_nop 2
    v_cmp_u_f32 vcc, v52, v52
    s_nop 0
    s_cbranch_vccnz W1B_RETRY
W1B_OK:
    v_permlane32_swap_b32 v48, v50
    v_permlane32_swap_b32 v49, v51
    v_dot2_f32_bf16 v52, v48, s61, 0
    v_dot2_f32_bf16 v52, v50, s61, v52
    v_dot2_f32_bf16 v53, v48, s46, 0
    v_dot2_f32_bf16 v53, v50, s46, v53
    v_dot2_f32_bf16 v54, v49, s61, 0
    v_dot2_f32_bf16 v54, v51, s61, v54
    v_dot2_f32_bf16 v55, v49, s46, 0
    v_dot2_f32_bf16 v55, v51, s46, v55
    s_nop 0
    v_permlane16_swap_b32 v52, v54
    s_nop 0
    v_permlane16_swap_b32 v53, v55
    v_add_f32 v52, v52, v54
    v_add_f32 v53, v53, v55
    v_cndmask_b32 v54, v53, v52, s[48:49]
    v_cndmask_b32 v60, v52, v53, s[48:49]
    s_nop 1
    v_add_f32_dpp v60, v54, v60 row_ror:8 row_mask:0xf bank_mask:0xf
    s_nop 1
    v_add_f32_dpp v60, v60, v60 quad_perm:[2,3,0,1] row_mask:0xf bank_mask:0xf
    s_nop 1
    v_add_f32_dpp v60, v60, v60 row_shr:4 row_mask:0xf bank_mask:0xa
    v_add_f32 v60, v60, v63
    v_cvt_pk_bf16_f32 v60, v60, v60
    s_mov_b32 exec_lo, 0xf0f0f0f0
    s_mov_b32 exec_hi, 0xf0f0f0f0
    ds_write_b16 v153, v60
    s_mov_b64 exec, -1
    s_waitcnt lgkmcnt(0)
    s_barrier
    s_cmp_eq_u32 s10, 0
    s_cbranch_scc1 G_CS2
G_CS2_DONE:
    v_mov_b32 v62, 0xc0135761
    s_barrier
    s_cmp_eq_u32 s3, 7
    s_cbranch_scc1 G_W7
    s_mov_b32 s64, 0xffffffff
    s_mov_b32 s65, 0x00000000
    s_mov_b64 s[70:71], -1
OP_30:
    s_and_b64 exec, s[70:71], s[64:65]
    global_load_dword v56, v155, s[72:73] sc1
    s_mov_b64 exec, s[70:71]
    global_load_dwordx4 v[48:51], v154, s[72:73] sc1
    global_load_dwordx4 v[52:55], v154, s[72:73] offset:896 sc1
    s_sub_u32 s11, s11, 1
    s_cbranch_scc1 OP_30_X
    s_waitcnt vmcnt(0)
    v_cmpx_o_f32 vcc, v48, v49
    v_cmpx_o_f32 vcc, v50, v51
    v_cmpx_o_f32 vcc, v52, v53
    v_cmpx_o_f32 vcc, v54, v55
    v_cmpx_o_f32 vcc, v56, v56
    s_nop 0
    s_andn2_b64 s[70:71], s[70:71], exec
    s_mov_b64 exec, s[70:71]
    s_cbranch_scc1 OP_30
OPD_31:
    s_mov_b64 exec, -1
    v_add_f32_dpp v68, v56, v56 quad_perm:[1,0,3,2] row_mask:0xf bank_mask:0xf
    s_nop 1
    v_add_f32_dpp v68, v68, v68 quad_perm:[2,3,0,1] row_mask:0xf bank_mask:0xf
    v_add_f32 v64, v48, v52
    s_nop 0
    v_add_f32_dpp v68, v68, v68 row_half_mirror row_mask:0xf bank_mask:0xf
    v_add_f32 v65, v49, v53
    s_nop 0
    v_add_f32_dpp v68, v68, v68 row_mirror row_mask:0xf bank_mask:0xf
    v_add_f32 v66, v50, v54
    v_readlane_b32 s12, v68, 0
    v_add_f32 v67, v51, v55
    v_readlane_b32 s13, v68, 16
    v_permlane16_swap_b32 v64, v65
    v_mov_b32 v70, 0x3b000000
    v_permlane16_swap_b32 v66, v67
    v_mov_b32 v71, 0x2edbe6ff
    v_add_f32 v64, v64, v65
    v_mul_f32 v69, s12, v70
    v_add_f32 v66, v66, v67
    v_mul_f32 v68, s13, v70
    s_nop 0
    v_permlane32_swap_b32 v64, v66
    v_fma_f32 v68, -v69, v69, v68
    v_add_f32 v60, v64, v66
    v_mov_b32 v70, 0x3f800054
    s_nop 0
    v_add_f32_dpp v60, v60, v60 row_ror:8 row_mask:0xf bank_mask:0xf
    v_fma_f32 v68, abs(v68), v70, v71
    v_rsq_f32 v68, v68
    s_nop 0
    v_mul_f32 v69, v69, v68
    v_fma_f32 v63, -v69, v162, v160
    v_fma_f32 v60, v60, v68, v63
    v_mul_f32 v61, v60, v60
    v_fmac_f32 v62, 0xbdd2d3e8, v61
    v_mul_f32 v62, v62, v60
    v_exp_f32 v62, v62
    s_nop 0
    v_add_f32 v62, 1.0, v62
    v_rcp_f32 v62, v62
    s_nop 0
    v_mul_f32 v60, v60, v62
    v_cvt_pk_bf16_f32 v60, v60, v60
    ds_write_b16 v156, v60
    s_waitcnt lgkmcnt(0)
G_W2_SKIP:
    s_barrier
    s_cmp_eq_u32 s10, 0
    s_cbranch_scc1 G_X_GO
    s_cmp_lg_u32 s7, 0
    s_cbranch_scc1 L_EXIT
    s_cmp_lg_u32 s3, s4
    s_cbranch_scc1 L_EXIT
G_X_GO:
    global_load_ushort v75, v158, s[72:73] sc1
G_RX_CHK:
    s_waitcnt vmcnt(0)
    v_lshlrev_b32 v63, 16, v75
    v_cmp_u_f32 vcc, v63, v63
    s_nop 0
    s_cbranch_vccnz G_RX_RETRY
G_RX_OK:
    v_add_f32 v63, v63, v161
    s_barrier
    s_sleep 6
    s_cmp_lg_u32 s10, 0
    s_cbranch_scc1 G_XS
    s_sleep 3
G_XS:
    s_mov_b64 s[70:71], -1
OP_32:
    global_load_dwordx4 v[48:51], v157, s[42:43] sc1
    global_load_dwordx4 v[52:55], v157, s[42:43] offset:256 sc1
    s_sub_u32 s11, s11, 1
    s_cbranch_scc1 OP_32_X
    s_waitcnt vmcnt(0)
    v_cmpx_o_f32 vcc, v48, v49
    v_cmpx_o_f32 vcc, v50, v51
    v_cmpx_o_f32 vcc, v52, v53
    v_cmpx_o_f32 vcc, v54, v55
    s_nop 0
    s_andn2_b64 s[70:71], s[70:71], exec
    s_mov_b64 exec, s[70:71]
    s_cbranch_scc1 OP_32
OPD_33:
    s_mov_b64 exec, -1
    v_pk_add_f32 v[48:49], v[48:49], v[52:53]
    v_pk_add_f32 v[50:51], v[50:51], v[54:55]
    s_nop 0
    v_permlane16_swap_b32 v48, v49
    v_permlane16_swap_b32 v50, v51
    v_add_f32 v48, v48, v49
    v_add_f32 v50, v50, v51
    s_nop 1
    v_permlane32_swap_b32 v48, v50
    v_add_f32 v60, v48, v50
    v_add_f32 v60, v60, v63
    v_cvt_pk_bf16_f32 v60, v60, v60
    s_cmp_lg_u32 s10, 0
    s_cbranch_scc1 G_FINAL
    ds_write_b16 v159, v60
    s_mov_b32 s10, 1
    s_add_u32 s42, s42, 2097152
    s_addc_u32 s43, s43, 0
    s_waitcnt lgkmcnt(0)
    s_barrier
    s_waitcnt vmcnt(0)
    s_branch G_ENTRY
G_FINAL:
    global_store_short v166, v60, s[36:37]
L_EXIT:
L_END:
    s_endpgm
S_AG0_X:
    s_mov_b32 s11, 0
    s_waitcnt vmcnt(0)
    s_branch S_AG0_DONE
SAFE_3:
    global_store_dwordx2 v159, v[112:113], s[72:73] sc1
    s_mov_b64 exec, 1
    global_store_dwordx2 v123, v[120:121], s[72:73] sc1
    s_mov_b64 exec, -1
    s_branch SEND_4
SAFE_8:
    s_mov_b32 exec_lo, 0x0000ffff
    s_mov_b32 exec_hi, 0x00000000
    global_store_dword v128, v139, s[72:73] sc1
    global_store_dword v129, v116, s[72:73] sc1
    s_mov_b32 exec_lo, s12
    global_store_dword v129, v88, s[72:73] offset:64 sc1
    s_mov_b64 exec, -1
    s_branch SEND_9
SAFE_13:
    s_nop 4
    global_store_dword v161, v112, s[72:73] sc1
    global_store_dword v161, v116, s[72:73] offset:64 sc1
    s_branch SEND_14
SAFE_15:
    s_nop 3
    global_store_dword v161, v112, s[72:73] sc1
    s_mov_b32 exec_lo, 0x00120011
    s_mov_b32 exec_hi, 0x00180014
    global_store_dword v162, v116, s[72:73] sc1
    s_mov_b32 exec_lo, 0x000f000f
    s_mov_b32 exec_hi, 0x000f000f
    global_store_dwordx4 v163, v[88:91], s[72:73] sc1
    s_mov_b64 exec, -1
    s_branch SEND_16
SAFE_18:
    s_mov_b32 exec_lo, 0xffffffff
    s_mov_b32 exec_hi, 0x00000003
    global_store_dwordx4 v4, v[8:11], s[72:73] sc1
    s_mov_b64 exec, -1
    s_branch SEND_19
SAFE_20:
    s_nop 3
    global_store_dword v150, v112, s[72:73] sc1
    s_mov_b32 exec_lo, 0x00120011
    s_mov_b32 exec_hi, 0x00180014
    global_store_dword v151, v116, s[72:73] sc1
    s_mov_b64 exec, -1
    s_branch SEND_21
OP_22_X:
    s_mov_b32 s11, 0
    s_waitcnt vmcnt(0)
    s_branch OPD_23
SAFE_24:
    s_mov_b32 exec_lo, 0xffffffff
    s_mov_b32 exec_hi, 0x00000000
    global_store_dwordx4 v4, v[8:11], s[72:73] sc1
    s_mov_b64 exec, -1
    s_branch SEND_25
VT_26:
    v_and_b32 v112, v140, v144
    v_and_b32_dpp v113, v140, v144 row_ror:12 row_mask:0xf bank_mask:0xf
    v_and_b32_dpp v114, v140, v144 row_ror:8 row_mask:0xf bank_mask:0xf
    v_and_b32_dpp v115, v140, v144 row_ror:4 row_mask:0xf bank_mask:0xf
    v_and_b32_dpp v116, v140, v145 row_ror:4 row_mask:0xf bank_mask:0xf
    v_and_b32 v117, v140, v145
    v_and_b32_dpp v118, v140, v145 row_ror:12 row_mask:0xf bank_mask:0xf
    v_and_b32_dpp v119, v140, v145 row_ror:8 row_mask:0xf bank_mask:0xf
    v_and_b32_dpp v120, v140, v146 row_ror:8 row_mask:0xf bank_mask:0xf
    v_and_b32_dpp v121, v140, v146 row_ror:4 row_mask:0xf bank_mask:0xf
    v_and_b32 v122, v140, v146
    v_and_b32_dpp v123, v140, v146 row_ror:12 row_mask:0xf bank_mask:0xf
    v_and_b32_dpp v124, v140, v147 row_ror:12 row_mask:0xf bank_mask:0xf
    v_and_b32_dpp v125, v140, v147 row_ror:8 row_mask:0xf bank_mask:0xf
    v_and_b32_dpp v126, v140, v147 row_ror:4 row_mask:0xf bank_mask:0xf
    v_and_b32 v127, v140, v147
    v_mov_b32 v132, 0x3f803f80
    v_mov_b32 v133, 0x3f803f80
    v_mov_b32 v134, 0x3f803f80
    v_mov_b32 v135, 0x3f803f80
    s_nop 1
    v_mfma_f32_16x16x32_bf16 v[128:131], v[132:135], v[112:115], 0
    s_waitcnt vmcnt(6)
    v_perm_b32 v80, v52, v48, s58
    v_perm_b32 v96, v54, v50, s58
    v_perm_b32 v84, v52, v48, s59
    v_perm_b32 v100, v54, v50, s59
    v_perm_b32 v88, v53, v49, s58
    v_perm_b32 v104, v55, v51, s58
    v_perm_b32 v92, v53, v49, s59
    v_perm_b32 v108, v55, v51, s59
    s_waitcnt vmcnt(4)
    v_perm_b32 v81, v60, v56, s58
    v_perm_b32 v97, v62, v58, s58
    v_perm_b32 v85, v60, v56, s59
    v_perm_b32 v101, v62, v58, s59
    v_perm_b32 v89, v61, v57, s58
    v_perm_b32 v105, v63, v59, s58
    v_perm_b32 v93, v61, v57, s59
    v_perm_b32 v109, v63, v59, s59
    s_waitcnt vmcnt(2)
    v_perm_b32 v82, v68, v64, s58
    v_perm_b32 v98, v70, v66, s58
    v_perm_b32 v86, v68, v64, s59
    v_perm_b32 v102, v70, v66, s59
    v_perm_b32 v90, v69, v65, s58
    v_perm_b32 v106, v71, v67, s58
    v_perm_b32 v94, v69, v65, s59
    v_perm_b32 v110, v71, v67, s59
    s_waitcnt vmcnt(0)
    v_perm_b32 v83, v76, v72, s58
    v_perm_b32 v99, v78, v74, s58
    v_perm_b32 v87, v76, v72, s59
    v_perm_b32 v103, v78, v74, s59
    v_perm_b32 v91, v77, v73, s58
    v_perm_b32 v107, v79, v75, s58
    v_perm_b32 v95, v77, v73, s59
    v_perm_b32 v111, v79, v75, s59
    v_mfma_f32_16x16x32_bf16 v[4:7], v[80:83], v[112:115], 0
    v_mfma_f32_16x16x32_bf16 v[8:11], v[96:99], v[112:115], 0
    v_mfma_f32_16x16x32_bf16 v[4:7], v[84:87], v[116:119], v[4:7]
    v_mfma_f32_16x16x32_bf16 v[8:11], v[100:103], v[116:119], v[8:11]
    v_mfma_f32_16x16x32_bf16 v[4:7], v[88:91], v[120:123], v[4:7]
    v_mfma_f32_16x16x32_bf16 v[8:11], v[104:107], v[120:123], v[8:11]
    v_mfma_f32_16x16x32_bf16 v[4:7], v[92:95], v[124:127], v[4:7]
    v_mfma_f32_16x16x32_bf16 v[8:11], v[108:111], v[124:127], v[8:11]
    v_mov_b32 v76, 0x3f803f80
    v_mov_b32 v77, 0x3f803f80
    v_mov_b32 v78, 0x3f803f80
    v_mov_b32 v79, 0x3f803f80
    s_branch VTD_27
OP_28_X:
    s_mov_b32 s11, 0
    s_waitcnt vmcnt(0)
    s_branch OPD_29
G_CS1:
    s_mul_i32 s12, s6, 14336
    s_add_u32 s12, s12, 86016
    v_subrev_u32 v72, s12, v154
    s_sleep 8
    global_load_dwordx4 v[64:67], v72, s[72:73] sc1
    global_load_dwordx4 v[68:71], v72, s[72:73] offset:896 sc1
    s_branch G_CS1_DONE
W1B_RETRY:
    s_mov_b64 exec, vcc
    global_load_dwordx4 v[48:51], v151, s[42:43] sc1
    s_mov_b64 exec, -1
    s_sub_u32 s11, s11, 1
    s_cbranch_scc0 W1B_CHK
    s_mov_b32 s11, 0
    s_waitcnt vmcnt(0)
    s_branch W1B_OK
G_CS2:
G_CS2_CHK:
    v_add_f32 v48, v64, v68
    v_add_f32 v49, v65, v69
    v_add_f32 v50, v66, v70
    v_add_f32 v51, v67, v71
    v_permlane16_swap_b32 v48, v49
    s_nop 0
    v_permlane16_swap_b32 v50, v51
    v_add_f32 v48, v48, v49
    v_add_f32 v50, v50, v51
    s_nop 1
    v_permlane32_swap_b32 v48, v50
    v_add_f32 v48, v48, v50
    s_nop 1
    v_add_f32_dpp v162, v48, v48 row_ror:8 row_mask:0xf bank_mask:0xf
    v_cmp_u_f32 vcc, v162, v162
    s_nop 0
    s_cbranch_vccz G_CS2_OK
    global_load_dwordx4 v[64:67], v72, s[72:73] sc1
    global_load_dwordx4 v[68:71], v72, s[72:73] offset:896 sc1
    s_waitcnt vmcnt(0)
    s_sub_u32 s11, s11, 1
    s_cbranch_scc0 G_CS2_CHK
    s_mov_b32 s11, 0
G_CS2_OK:
    v_lshlrev_b32 v160, 16, v160
    v_lshlrev_b32 v161, 16, v161
    s_branch G_CS2_DONE
G_W7:
    s_cmp_lg_u32 s2, 0
    s_cbranch_scc1 G_W2_SKIP
    s_cmp_eq_u32 s10, 0
    s_cbranch_scc1 G_W2_SKIP
    v_mov_b32 v12, 0
    v_mov_b32 v4, 0
    v_mov_b32 v5, 0
    s_mov_b64 exec, 1
    global_store_dwordx2 v12, v[4:5], s[38:39] sc1
    s_mov_b64 exec, -1
    s_branch G_W2_SKIP
OP_30_X:
    s_mov_b32 s11, 0
    s_waitcnt vmcnt(0)
    s_branch OPD_31
G_RX_RETRY:
    global_load_ushort v75, v158, s[72:73] sc1
    s_sub_u32 s11, s11, 1
    s_cbranch_scc0 G_RX_CHK
    s_mov_b32 s11, 0
    s_branch G_RX_OK
OP_32_X:
    s_mov_b32 s11, 0
    s_waitcnt vmcnt(0)
    s_branch OPD_33
    s_endpgm
    .fill ((12288 + 256 - (. - interleave_layers__sliding_block_cached__mixer_channel_mlp__decode_kernel)) / 4), 4, 0xbf810000
.section .rodata,"a"
.p2align 6
.amdhsa_kernel interleave_layers__sliding_block_cached__mixer_channel_mlp__decode_kernel
  .amdhsa_next_free_vgpr 168
  .amdhsa_next_free_sgpr 102
  .amdhsa_accum_offset 168
  .amdhsa_group_segment_fixed_size 0
  .amdhsa_kernarg_size 104
  .amdhsa_user_sgpr_count 2
  .amdhsa_user_sgpr_kernarg_segment_ptr 1
  .amdhsa_system_sgpr_workgroup_id_x 1
.end_amdhsa_kernel
```
